```python
import torch

def _softmax(x, axis=-1):
    return torch.softmax(x, dim=axis)
def _gelu(x):
    return torch.nn.functional.gelu(x, approximate="tanh")
def _silu(x):
    return torch.nn.functional.silu(x)
def _sigmoid(x):
    return torch.sigmoid(x)
def _layernorm(x, axis=-1, eps=1e-5):
    m = x.mean(dim=axis, keepdim=True)
    v = x.var(dim=axis, keepdim=True, unbiased=False)
    return (x - m) / torch.sqrt(v + eps)
def _scatter_add(tgt, idx, src, axis=0):
    return tgt.clone().index_add_(axis, idx, src)
def _segment_sum(src, seg, n):
    out = torch.zeros((n,) + src.shape[1:], dtype=src.dtype)
    return out.index_add_(0, seg, src)
def _pad(x, pw):
    flat = tuple(v for pair in reversed(pw) for v in pair)
    return torch.nn.functional.pad(x, flat)

kernel_name = 'concat_heads__gqa_block_cached__gqa_block_cached__decode'

def setup_inputs():

    _w = (lambda a: (lambda t: t.to(torch.bfloat16) if t.is_floating_point() else t)(torch.as_tensor(a)))
    def _A_setup():
        B, Sq, D = 1, 1, 576
        Hq, Hkv, Sk, Dh = 32, 16, 16384, 128
        assert Hq % Hkv == 0, (Hq, Hkv)
        return {
            "x": _w((lambda *s: torch.randn(*s, dtype=torch.bfloat16) * 0.8)(B, Sq, D)),
            "k_cache": _w((lambda *s: torch.randn(*s, dtype=torch.bfloat16) * 0.8)(B, Hkv, Sk, Dh)),
            "v_cache": _w((lambda *s: torch.randn(*s, dtype=torch.bfloat16) * 0.05)(B, Hkv, Sk, Dh)),
            "wq": _w((lambda *s: torch.randn(*s, dtype=torch.bfloat16) * 0.8)(D, Hq * Dh) * (D ** -0.5)),
            "wo": _w((lambda *s: torch.randn(*s, dtype=torch.bfloat16) * 0.05)(Hq * Dh, D) * ((Hq * Dh) ** -0.5)),
        }
    _A_in = _A_setup()

    def _B_setup():
        B, Sq, D = 1, 1, 576
        Hq, Hkv, Sk, Dh = 32, 16, 16384, 128
        assert Hq % Hkv == 0, (Hq, Hkv)
        return {
            "x": _w((lambda *s: torch.randn(*s, dtype=torch.bfloat16) * 0.8)(B, Sq, D)),
            "k_cache": _w((lambda *s: torch.randn(*s, dtype=torch.bfloat16) * 0.8)(B, Hkv, Sk, Dh)),
            "v_cache": _w((lambda *s: torch.randn(*s, dtype=torch.bfloat16) * 0.05)(B, Hkv, Sk, Dh)),
            "wq": _w((lambda *s: torch.randn(*s, dtype=torch.bfloat16) * 0.8)(D, Hq * Dh) * (D ** -0.5)),
            "wo": _w((lambda *s: torch.randn(*s, dtype=torch.bfloat16) * 0.05)(Hq * Dh, D) * ((Hq * Dh) ** -0.5)),
        }
    _B_in = _B_setup()

    return {
        "A_x": _A_in["x"],
        "A_k_cache": _A_in["k_cache"],
        "A_v_cache": _A_in["v_cache"],
        "A_wq": _A_in["wq"],
        "A_wo": _A_in["wo"],
        "B_x": _B_in["x"],
        "B_k_cache": _B_in["k_cache"],
        "B_v_cache": _B_in["v_cache"],
        "B_wq": _B_in["wq"],
        "B_wo": _B_in["wo"],
    }

def reference(A_x, A_k_cache, A_v_cache, A_wq, A_wo, B_x, B_k_cache, B_v_cache, B_wq, B_wo):
    def _A_ref(x, k_cache, v_cache, wq, wo):
        B, Sq, D = x.shape
        Hq, Dh = 32, 128
        Hkv = k_cache.shape[1]
        rep = Hq // Hkv
        q = (lambda x, *d: x.permute(*d))((x @ wq).reshape(B, Sq, Hq, Dh), 0, 2, 1, 3)
        k = (lambda x, n, axis: torch.repeat_interleave(x, n, dim=axis))(k_cache, rep, axis=1)
        v = (lambda x, n, axis: torch.repeat_interleave(x, n, dim=axis))(v_cache, rep, axis=1)
        scores = torch.einsum("bhqd,bhkd->bhqk", q, k) * (Dh ** -0.5)
        p = _softmax(scores, axis=-1)
        o = torch.einsum("bhqk,bhkd->bhqd", p, v)
        return (lambda x, *d: x.permute(*d))(o, 0, 2, 1, 3).reshape(B, Sq, Hq * Dh) @ wo

    def _B_ref(x, k_cache, v_cache, wq, wo):
        B, Sq, D = x.shape
        Hq, Dh = 32, 128
        Hkv = k_cache.shape[1]
        rep = Hq // Hkv
        q = (lambda x, *d: x.permute(*d))((x @ wq).reshape(B, Sq, Hq, Dh), 0, 2, 1, 3)
        k = (lambda x, n, axis: torch.repeat_interleave(x, n, dim=axis))(k_cache, rep, axis=1)
        v = (lambda x, n, axis: torch.repeat_interleave(x, n, dim=axis))(v_cache, rep, axis=1)
        scores = torch.einsum("bhqd,bhkd->bhqk", q, k) * (Dh ** -0.5)
        p = _softmax(scores, axis=-1)
        o = torch.einsum("bhqk,bhkd->bhqd", p, v)
        return (lambda x, *d: x.permute(*d))(o, 0, 2, 1, 3).reshape(B, Sq, Hq * Dh) @ wo

    a = _A_ref(A_x, A_k_cache, A_v_cache, A_wq, A_wo)
    b = _B_ref(B_x, B_k_cache, B_v_cache, B_wq, B_wo)
    return torch.concatenate([a, b], axis=-1)
```

```asm
; @launch grid=(256,1,1) block=(256,1,1) lds=8192
.amdgcn_target "amdgcn-amd-amdhsa--gfx950"
.text
.globl concat_heads__gqa_block_cached__gqa_block_cached__decode_kernel
.p2align 8
.type concat_heads__gqa_block_cached__gqa_block_cached__decode_kernel,@function
concat_heads__gqa_block_cached__gqa_block_cached__decode_kernel:
  s_cmp_ge_u32 s2, 256
  s_cbranch_scc1 L_end
  s_lshr_b32 s3, s2, 7
  s_mul_i32 s18, s3, 40
  s_add_u32 s18, s0, s18
  s_addc_u32 s19, s1, 0
  s_load_dwordx8 s[8:15], s[18:19], 0
  s_load_dwordx2 s[16:17], s[18:19], 32
  s_load_dwordx4 s[20:23], s[0:1], 80
  s_load_dwordx2 s[24:25], s[0:1], 96
  s_getpc_b64 s[64:65]
  v_lshlrev_b32 v36, 4, v0
  s_and_b32 s64, s64, 0xffffff00
  s_mov_b32 s72, L_code_end-concat_heads__gqa_block_cached__gqa_block_cached__decode_kernel-16
  v_min_u32 v37, s72, v36
  global_load_dwordx4 v[216:219], v37, s[64:65]
  v_add_u32 v36, 4096, v36
  v_min_u32 v37, s72, v36
  global_load_dwordx4 v[220:223], v37, s[64:65]
  s_lshr_b32 s7, s2, 3
  s_and_b32 s4, s7, 15
  s_and_b32 s5, s2, 7
  v_and_b32 v1, 63, v0
  v_lshrrev_b32 v36, 6, v0
  s_nop 0
  v_readfirstlane_b32 s6, v36
  v_lshrrev_b32 v39, 3, v1
  v_and_b32 v37, 7, v1
  v_lshlrev_b32 v37, 4, v37
  v_lshl_add_u32 v37, v39, 13, v37
  v_lshlrev_b32 v38, 1, v39
  v_mov_b32 v255, 0
  v_mov_b32 v241, 160
  s_and_b32 s72, s5, 1
  s_mul_i32 s72, s72, 288
  s_mul_i32 s73, s6, 72
  s_add_u32 s72, s72, s73
  s_lshl_b32 s73, s72, 1
  s_lshl_b32 s74, s72, 13
  s_lshl_b32 s75, s4, 9
  s_add_u32 s74, s74, s75
  s_lshr_b32 s75, s5, 1
  s_lshl_b32 s75, s75, 7
  s_add_u32 s74, s74, s75
  s_lshl_b32 s76, s3, 8
  s_lshl_b32 s77, s7, 8
  s_add_u32 s77, s77, 196608
  s_lshl_b32 s78, s5, 2
  s_add_u32 s78, s78, s6
  s_cmp_eq_u32 s78, 0
  s_cselect_b32 s79, s77, 0x7f000000
  s_waitcnt lgkmcnt(0)
  s_mov_b32 s36, s14
  s_and_b32 s37, s15, 0xffff
  s_mov_b32 s38, 4718592
  s_mov_b32 s39, 0x20000
  buffer_load_dwordx4 v[56:59], v37, s[36:39], s74 offen nt
  s_add_u32 s74, s74, 65536
  buffer_load_dwordx4 v[60:63], v37, s[36:39], s74 offen nt
  s_add_u32 s74, s74, 65536
  buffer_load_dwordx4 v[64:67], v37, s[36:39], s74 offen nt
  s_add_u32 s74, s74, 65536
  s_mov_b32 s44, s8
  s_and_b32 s45, s9, 0xffff
  s_mov_b32 s46, 1160
  s_mov_b32 s47, 0x20000
  buffer_load_ushort v232, v38, s[44:47], s73 offen offset:0
  buffer_load_ushort v233, v38, s[44:47], s73 offen offset:16
  buffer_load_ushort v234, v38, s[44:47], s73 offen offset:32
  buffer_load_ushort v235, v38, s[44:47], s73 offen offset:48
  buffer_load_ushort v236, v38, s[44:47], s73 offen offset:64
  buffer_load_ushort v237, v38, s[44:47], s73 offen offset:80
  buffer_load_ushort v238, v38, s[44:47], s73 offen offset:96
  buffer_load_ushort v239, v38, s[44:47], s73 offen offset:112
  buffer_load_ushort v240, v38, s[44:47], s73 offen offset:128
  buffer_load_dwordx4 v[68:71], v37, s[36:39], s74 offen nt
  s_add_u32 s74, s74, 65536
  buffer_load_dwordx4 v[72:75], v37, s[36:39], s74 offen nt
  s_add_u32 s74, s74, 65536
  buffer_load_dwordx4 v[76:79], v37, s[36:39], s74 offen nt
  s_add_u32 s74, s74, 65536
  buffer_load_dwordx4 v[80:83], v37, s[36:39], s74 offen nt
  s_add_u32 s74, s74, 65536
  buffer_load_dwordx4 v[84:87], v37, s[36:39], s74 offen nt
  s_add_u32 s74, s74, 65536
  buffer_load_dwordx4 v[88:91], v37, s[36:39], s74 offen nt
  s_mov_b32 s52, s24
  s_and_b32 s53, s25, 0xffff
  s_mov_b32 s54, 2490368
  s_mov_b32 s55, 0x20000
  buffer_load_dwordx2 v[242:243], v255, s[52:55], s76 offen sc1
  s_mov_b64 exec, 1
  buffer_store_dword v241, v255, s[52:55], s79 offen sc1
  s_mov_b64 exec, -1
  s_add_u32 s26, s24, s77
  s_addc_u32 s27, s25, 0
  s_mov_b32 s28, s10
  s_and_b32 s29, s11, 0xffff
  s_mov_b32 s30, 67108864
  s_mov_b32 s31, 0x20000
  s_mov_b32 s32, s12
  s_and_b32 s33, s13, 0xffff
  s_mov_b32 s34, 67108864
  s_mov_b32 s35, 0x20000
  s_mov_b32 s40, s16
  s_and_b32 s41, s17, 0xffff
  s_mov_b32 s42, 4718592
  s_mov_b32 s43, 0x20000
  s_mov_b32 s48, s20
  s_and_b32 s49, s21, 0xffff
  s_mov_b32 s50, 2308
  s_mov_b32 s51, 0x20000
  s_mov_b32 s17, s76
  v_and_b32 v2, 3, v1
  v_lshlrev_b32 v2, 4, v2
  v_bfe_u32 v36, v1, 2, 2
  v_lshl_add_u32 v2, v36, 8, v2
  v_lshrrev_b32 v36, 4, v1
  v_lshl_add_u32 v2, v36, 6, v2
  v_lshlrev_b32 v3, 4, v1
  s_lshl_b32 s58, s4, 22
  s_lshl_b32 s72, s78, 12
  s_add_u32 s68, s58, s72
  s_add_u32 s69, s68, 131072
  s_add_u32 s70, s68, 262144
  s_add_u32 s71, s68, 393216
  s_mov_b32 s59, 0
  v_and_b32 v36, 1, v1
  v_lshlrev_b32 v36, 4, v36
  v_mov_b32 v37, 0xffff
  v_lshlrev_b32 v37, v36, v37
  v_bfe_u32 v36, v1, 1, 2
  v_cmp_eq_u32 vcc, 0, v36
  s_nop 1
  v_cndmask_b32 v4, 0, v37, vcc
  v_cmp_eq_u32 vcc, 1, v36
  s_nop 1
  v_cndmask_b32 v5, 0, v37, vcc
  v_cmp_eq_u32 vcc, 2, v36
  s_nop 1
  v_cndmask_b32 v6, 0, v37, vcc
  v_cmp_eq_u32 vcc, 3, v36
  s_nop 1
  v_cndmask_b32 v7, 0, v37, vcc
  v_mov_b32 v16, 0x7f800000
  v_mov_b32 v17, 0
  v_mov_b32 v18, 0x3e0293ee
  v_mov_b32 v20, 0
  v_mov_b32 v21, 0
  v_mov_b32 v22, 0
  v_mov_b32 v23, 0
  s_mov_b32 s62, 1048576
  v_bfe_u32 v36, v1, 4, 1
  v_lshlrev_b32 v36, 7, v36
  v_lshrrev_b32 v37, 5, v1
  v_lshl_add_u32 v36, v37, 5, v36
  v_and_b32 v37, 7, v1
  v_lshl_add_u32 v36, v37, 2, v36
  s_lshl_b32 s72, s6, 8
  v_add_u32 v36, s72, v36
  s_lshl_b32 s72, s6, 3
  v_add_u32 v37, s72, v1
  v_lshlrev_b32 v38, 4, v37
  v_lshlrev_b32 v37, 3, v37
  v_lshlrev_b32 v39, 4, v0
  s_lshl_b32 s72, s7, 12
  s_add_u32 s72, s72, 4096
  s_lshl_b32 s73, s5, 9
  s_add_u32 s73, s73, s72
  s_waitcnt vmcnt(8)
  buffer_load_dwordx4 v[104:107], v2, s[28:31], s68 offen offset:0 nt
  v_lshl_or_b32 v34, v232, 16, v232
  v_and_b32 v40, v34, v4
  v_and_b32 v41, v34, v5
  v_and_b32 v42, v34, v6
  v_and_b32 v43, v34, v7
  s_nop 1
  v_mfma_f32_16x16x32_bf16 v[24:27], v[56:59], v[40:43], 0
  buffer_load_dwordx4 v[108:111], v2, s[28:31], s68 offen offset:1024 nt
  v_lshl_or_b32 v34, v233, 16, v233
  v_and_b32 v44, v34, v4
  v_and_b32 v45, v34, v5
  v_and_b32 v46, v34, v6
  v_and_b32 v47, v34, v7
  s_nop 1
  v_mfma_f32_16x16x32_bf16 v[24:27], v[60:63], v[44:47], v[24:27]
  buffer_load_dwordx4 v[112:115], v2, s[28:31], s68 offen offset:2048 nt
  v_lshl_or_b32 v34, v234, 16, v234
  v_and_b32 v40, v34, v4
  v_and_b32 v41, v34, v5
  v_and_b32 v42, v34, v6
  v_and_b32 v43, v34, v7
  s_nop 1
  v_mfma_f32_16x16x32_bf16 v[24:27], v[64:67], v[40:43], v[24:27]
  s_waitcnt vmcnt(10)
  buffer_load_dwordx4 v[116:119], v2, s[28:31], s68 offen offset:3072 nt
  v_lshl_or_b32 v34, v235, 16, v235
  v_and_b32 v44, v34, v4
  v_and_b32 v45, v34, v5
  v_and_b32 v46, v34, v6
  v_and_b32 v47, v34, v7
  s_nop 1
  v_mfma_f32_16x16x32_bf16 v[24:27], v[68:71], v[44:47], v[24:27]
  s_waitcnt vmcnt(10)
  buffer_load_dwordx4 v[120:123], v3, s[32:35], s68 offen offset:0 nt
  v_lshl_or_b32 v34, v236, 16, v236
  v_and_b32 v40, v34, v4
  v_and_b32 v41, v34, v5
  v_and_b32 v42, v34, v6
  v_and_b32 v43, v34, v7
  s_nop 1
  v_mfma_f32_16x16x32_bf16 v[24:27], v[72:75], v[40:43], v[24:27]
  s_waitcnt vmcnt(10)
  buffer_load_dwordx4 v[124:127], v3, s[32:35], s68 offen offset:1024 nt
  v_lshl_or_b32 v34, v237, 16, v237
  v_and_b32 v44, v34, v4
  v_and_b32 v45, v34, v5
  v_and_b32 v46, v34, v6
  v_and_b32 v47, v34, v7
  s_nop 1
  v_mfma_f32_16x16x32_bf16 v[24:27], v[76:79], v[44:47], v[24:27]
  s_waitcnt vmcnt(10)
  buffer_load_dwordx4 v[128:131], v3, s[32:35], s68 offen offset:2048 nt
  v_lshl_or_b32 v34, v238, 16, v238
  v_and_b32 v40, v34, v4
  v_and_b32 v41, v34, v5
  v_and_b32 v42, v34, v6
  v_and_b32 v43, v34, v7
  s_nop 1
  v_mfma_f32_16x16x32_bf16 v[24:27], v[80:83], v[40:43], v[24:27]
  s_waitcnt vmcnt(10)
  buffer_load_dwordx4 v[132:135], v3, s[32:35], s68 offen offset:3072 nt
  v_lshl_or_b32 v34, v239, 16, v239
  v_and_b32 v44, v34, v4
  v_and_b32 v45, v34, v5
  v_and_b32 v46, v34, v6
  v_and_b32 v47, v34, v7
  s_nop 1
  v_mfma_f32_16x16x32_bf16 v[24:27], v[84:87], v[44:47], v[24:27]
  s_waitcnt vmcnt(10)
  v_lshl_or_b32 v34, v240, 16, v240
  v_and_b32 v40, v34, v4
  v_and_b32 v41, v34, v5
  v_and_b32 v42, v34, v6
  v_and_b32 v43, v34, v7
  s_nop 1
  v_mfma_f32_16x16x32_bf16 v[24:27], v[88:91], v[40:43], v[24:27]
  s_nop 7
  v_permlane32_swap_b32 v24, v25
  v_permlane32_swap_b32 v26, v27
  s_nop 0
  v_add_f32_dpp v24, v25, v24 row_ror:8 row_mask:0xf bank_mask:0xf
  v_add_f32_dpp v26, v27, v26 row_ror:8 row_mask:0xf bank_mask:0xf
  s_mov_b32 exec_lo, 0x00ff00ff
  s_mov_b32 exec_hi, 0x00ff00ff
  ds_write2_b32 v36, v24, v26 offset0:0 offset1:16
  s_mov_b64 exec, -1
  s_waitcnt vmcnt(8)
  v_readfirstlane_b32 s56, v242
  v_readfirstlane_b32 s57, v243
  s_add_u32 s56, s56, 1
  s_add_u32 s57, s57, 0x9e3779b9
  s_waitcnt lgkmcnt(0)
  s_barrier
  ds_read_b64 v[232:233], v37 offset:0
  ds_read_b64 v[234:235], v37 offset:256
  ds_read_b64 v[236:237], v37 offset:512
  ds_read_b64 v[238:239], v37 offset:768
  v_mov_b32 v29, s56
  v_mov_b32 v31, s57
  s_waitcnt lgkmcnt(0)
  v_add_f32 v232, v232, v234
  v_add_f32 v233, v233, v235
  v_add_f32 v236, v236, v238
  v_add_f32 v237, v237, v239
  v_add_f32 v28, v232, v236
  v_add_f32 v30, v233, v237
  s_mov_b64 exec, 0xff
  buffer_store_dwordx4 v[28:31], v38, s[52:55], s73 offen sc1
  s_mov_b64 exec, -1
  buffer_load_dwordx4 v[136:139], v2, s[28:31], s69 offen offset:0 nt
  buffer_load_dwordx4 v[140:143], v2, s[28:31], s69 offen offset:1024 nt
  buffer_load_dwordx4 v[144:147], v2, s[28:31], s69 offen offset:2048 nt
  buffer_load_dwordx4 v[148:151], v2, s[28:31], s69 offen offset:3072 nt
  buffer_load_dwordx4 v[152:155], v3, s[32:35], s69 offen offset:0 nt
  buffer_load_dwordx4 v[156:159], v3, s[32:35], s69 offen offset:1024 nt
  buffer_load_dwordx4 v[160:163], v3, s[32:35], s69 offen offset:2048 nt
  buffer_load_dwordx4 v[164:167], v3, s[32:35], s69 offen offset:3072 nt
  v_lshlrev_b32 v244, 4, v0
  v_bfe_u32 v40, v1, 3, 1
  v_lshlrev_b32 v250, 3, v40
  v_lshlrev_b32 v252, 4, v40
  s_lshl_b32 s74, s6, 4
  v_add_u32 v245, s74, v250
  v_lshlrev_b32 v249, 4, v1
  v_lshlrev_b32 v251, 5, v1
  v_lshlrev_b32 v253, 1, v1
  v_and_b32 v40, 7, v1
  v_lshlrev_b32 v247, 12, v40
  v_lshrrev_b32 v41, 3, v1
  v_lshl_add_u32 v246, v41, 5, v247
  v_mul_u32_u24 v254, 1152, v41
  v_lshl_add_u32 v254, v40, 4, v254
  s_mul_i32 s74, s6, 384
  s_cmp_eq_u32 s6, 3
  s_cselect_b32 s74, 0x40000000, s74
  v_add_u32 v254, s74, v254
  s_lshl_b32 s60, s4, 3
  s_add_u32 s60, s60, s5
  s_mul_i32 s60, s60, 36864
  v_bfe_u32 v40, v1, 4, 1
  v_lshlrev_b32 v248, 15, v40
  v_lshrrev_b32 v40, 5, v1
  v_lshl_add_u32 v248, v40, 14, v248
  v_bfe_u32 v40, v1, 2, 1
  v_lshl_add_u32 v248, v40, 13, v248
  v_and_b32 v40, 3, v1
  v_lshl_add_u32 v248, v40, 4, v248
  s_lshl_b32 s74, s7, 15
  s_add_u32 s74, s74, 262144
  s_lshl_b32 s8, s5, 12
  s_add_u32 s8, s8, s74
  s_and_b32 s9, s5, 3
  s_lshl_b32 s9, s9, 9
  s_lshr_b32 s75, s5, 2
  s_lshl_b32 s76, s75, 8
  s_add_u32 s9, s9, s76
  s_add_u32 s9, s9, s74
  s_lshl_b32 s10, s75, 4
  s_add_u32 s10, s10, s74
  s_and_b32 s63, s2, 127
  s_mul_i32 s74, s3, 589824
  s_add_u32 s74, s74, 1310720
  s_lshl_b32 s75, s63, 6
  s_add_u32 s11, s74, s75
  s_mul_i32 s75, s6, 196608
  s_add_u32 s11, s11, s75
  s_add_u32 s12, s11, 65536
  s_add_u32 s13, s11, 131072
  s_lshl_b32 s75, s63, 13
  s_add_u32 s14, s74, s75
  s_add_u32 s15, s14, 4096
  s_lshr_b32 s74, s63, 3
  s_lshl_b32 s74, s74, 6
  s_bfe_u32 s75, s63, 0x10002
  s_lshl_b32 s75, s75, 5
  s_add_u32 s74, s74, s75
  s_bfe_u32 s75, s63, 0x10001
  s_lshl_b32 s75, s75, 3
  s_add_u32 s74, s74, s75
  s_and_b32 s75, s63, 1
  s_lshl_b32 s75, s75, 2
  s_add_u32 s74, s74, s75
  s_mul_i32 s75, s3, 576
  s_add_u32 s74, s74, s75
  s_lshl_b32 s16, s74, 1
  v_lshrrev_b32 v40, 5, v1
  v_lshlrev_b32 v42, 10, v40
  v_and_b32 v40, 31, v1
  v_lshl_add_u32 v42, v40, 3, v42
  s_lshl_b32 s74, s6, 8
  s_add_u32 s74, s74, 1024
  v_add_u32 v42, s74, v42
  v_bfe_u32 v40, v1, 3, 1
  v_lshlrev_b32 v43, 9, v40
  v_lshrrev_b32 v40, 4, v1
  v_lshl_add_u32 v43, v40, 7, v43
  v_and_b32 v40, 3, v1
  v_lshl_add_u32 v43, v40, 5, v43
  buffer_load_dwordx4 v[240:243], v39, s[52:55], s72 offen sc1
  buffer_load_dwordx4 v[168:171], v2, s[28:31], s70 offen offset:0 nt
  buffer_load_dwordx4 v[172:175], v2, s[28:31], s70 offen offset:1024 nt
  buffer_load_dwordx4 v[176:179], v2, s[28:31], s70 offen offset:2048 nt
  buffer_load_dwordx4 v[180:183], v2, s[28:31], s70 offen offset:3072 nt
  buffer_load_dwordx4 v[184:187], v3, s[32:35], s70 offen offset:0 nt
  buffer_load_dwordx4 v[188:191], v3, s[32:35], s70 offen offset:1024 nt
  buffer_load_dwordx4 v[192:195], v3, s[32:35], s70 offen offset:2048 nt
  buffer_load_dwordx4 v[196:199], v3, s[32:35], s70 offen offset:3072 nt
  s_waitcnt vmcnt(8)
  v_cmp_ne_u32 vcc, s56, v241
  v_cmp_ne_u32_e64 s[66:67], s57, v243
  s_or_b64 s[64:65], vcc, s[66:67]
  s_cmp_eq_u64 s[64:65], 0
  s_nop 1
  s_cbranch_scc1 L_got2
  s_mov_b64 exec, s[64:65]
  buffer_load_dwordx4 v[240:243], v39, s[52:55], s72 offen sc1
  s_mov_b64 exec, -1
  buffer_load_dwordx4 v[200:203], v2, s[28:31], s71 offen offset:0 nt
  buffer_load_dwordx4 v[204:207], v2, s[28:31], s71 offen offset:1024 nt
  buffer_load_dwordx4 v[208:211], v2, s[28:31], s71 offen offset:2048 nt
  buffer_load_dwordx4 v[212:215], v2, s[28:31], s71 offen offset:3072 nt
  buffer_load_dwordx4 v[216:219], v3, s[32:35], s71 offen offset:0 nt
  buffer_load_dwordx4 v[220:223], v3, s[32:35], s71 offen offset:1024 nt
  buffer_load_dwordx4 v[224:227], v3, s[32:35], s71 offen offset:2048 nt
  buffer_load_dwordx4 v[228:231], v3, s[32:35], s71 offen offset:3072 nt
  s_waitcnt vmcnt(8)
  v_cmp_ne_u32 vcc, s56, v241
  v_cmp_ne_u32_e64 s[66:67], s57, v243
  s_or_b64 s[64:65], vcc, s[66:67]
  s_cmp_eq_u64 s[64:65], 0
  s_nop 1
  s_cbranch_scc1 L_got3
L_poll0:
  s_mov_b64 exec, s[64:65]
  buffer_load_dwordx4 v[240:243], v39, s[52:55], s72 offen sc1
  s_mov_b64 exec, -1
  s_sub_u32 s62, s62, 1
  s_cbranch_scc1 L_end
  s_waitcnt vmcnt(0)
  v_cmp_ne_u32 vcc, s56, v241
  v_cmp_ne_u32_e64 s[66:67], s57, v243
  s_or_b64 s[64:65], vcc, s[66:67]
  s_cmp_eq_u64 s[64:65], 0
  s_nop 1
  s_cbranch_scc0 L_poll0
  s_branch L_got3
L_got2:
  buffer_load_dwordx4 v[200:203], v2, s[28:31], s71 offen offset:0 nt
  buffer_load_dwordx4 v[204:207], v2, s[28:31], s71 offen offset:1024 nt
  buffer_load_dwordx4 v[208:211], v2, s[28:31], s71 offen offset:2048 nt
  buffer_load_dwordx4 v[212:215], v2, s[28:31], s71 offen offset:3072 nt
  buffer_load_dwordx4 v[216:219], v3, s[32:35], s71 offen offset:0 nt
  buffer_load_dwordx4 v[220:223], v3, s[32:35], s71 offen offset:1024 nt
  buffer_load_dwordx4 v[224:227], v3, s[32:35], s71 offen offset:2048 nt
  buffer_load_dwordx4 v[228:231], v3, s[32:35], s71 offen offset:3072 nt
L_got3:
  ds_write2_b32 v42, v240, v242 offset0:0 offset1:1
  v_and_b32 v37, 4, v1
  v_cmp_ne_u32 vcc, 0, v37
  v_mov_b32 v36, v43
  s_waitcnt lgkmcnt(0)
  s_barrier
  s_mov_b32 s61, 1
  s_atomic_add s61, s[26:27], 0x0 glc
  ds_read_b128 v[40:43], v36 offset:1024
  ds_read_b128 v[44:47], v36 offset:1040
  ds_read_b128 v[48:51], v36 offset:2048
  ds_read_b128 v[52:55], v36 offset:2064
  s_waitcnt lgkmcnt(0)
  v_add_f32 v40, v40, v48
  v_add_f32 v41, v41, v49
  v_add_f32 v42, v42, v50
  v_add_f32 v43, v43, v51
  v_add_f32 v44, v44, v52
  v_add_f32 v45, v45, v53
  v_add_f32 v46, v46, v54
  v_add_f32 v47, v47, v55
  v_cvt_pk_bf16_f32 v48, v40, v41
  v_cvt_pk_bf16_f32 v49, v42, v43
  v_cvt_pk_bf16_f32 v50, v44, v45
  v_cvt_pk_bf16_f32 v51, v46, v47
  v_cndmask_b32 v12, 0, v48, vcc
  v_cndmask_b32_e64 v8, v48, 0, vcc
  v_cndmask_b32 v13, 0, v49, vcc
  v_cndmask_b32_e64 v9, v49, 0, vcc
  v_cndmask_b32 v14, 0, v50, vcc
  v_cndmask_b32_e64 v10, v50, 0, vcc
  v_cndmask_b32 v15, 0, v51, vcc
  v_cndmask_b32_e64 v11, v51, 0, vcc
  s_waitcnt vmcnt(28)
  s_nop 0
  v_mfma_f32_16x16x32_bf16 v[24:27], v[104:107], v[8:11], 0
  v_mfma_f32_16x16x32_bf16 v[28:31], v[112:115], v[8:11], 0
  v_mfma_f32_16x16x32_bf16 v[24:27], v[108:111], v[12:15], v[24:27]
  v_mfma_f32_16x16x32_bf16 v[28:31], v[116:119], v[12:15], v[28:31]
  s_add_u32 s68, s68, 524288
  buffer_load_dwordx4 v[104:107], v2, s[28:31], s68 offen offset:0 nt
  buffer_load_dwordx4 v[108:111], v2, s[28:31], s68 offen offset:1024 nt
  buffer_load_dwordx4 v[112:115], v2, s[28:31], s68 offen offset:2048 nt
  buffer_load_dwordx4 v[116:119], v2, s[28:31], s68 offen offset:3072 nt
  v_mov_b32 v32, v16
  v_mov_b32 v33, v16
  s_nop 0
  v_fmac_f32_dpp v32, v24, v18 quad_perm:[0,0,0,0] row_mask:0xf bank_mask:0xf
  v_fmac_f32_dpp v33, v28, v18 quad_perm:[0,0,0,0] row_mask:0xf bank_mask:0xf
  s_nop 0
  v_fmac_f32_dpp v32, v25, v18 quad_perm:[1,1,1,1] row_mask:0xf bank_mask:0xf
  v_fmac_f32_dpp v33, v29, v18 quad_perm:[1,1,1,1] row_mask:0xf bank_mask:0xf
  s_nop 0
  v_fmac_f32_dpp v32, v26, v18 quad_perm:[2,2,2,2] row_mask:0xf bank_mask:0xf
  v_fmac_f32_dpp v33, v30, v18 quad_perm:[2,2,2,2] row_mask:0xf bank_mask:0xf
  s_nop 0
  v_fmac_f32_dpp v32, v27, v18 quad_perm:[3,3,3,3] row_mask:0xf bank_mask:0xf
  v_fmac_f32_dpp v33, v31, v18 quad_perm:[3,3,3,3] row_mask:0xf bank_mask:0xf
  v_max_f32 v36, v32, v33
  v_cmp_lt_f32 vcc, 0, v36
  s_cbranch_vccnz L_tramp0
L_back0:
  v_exp_f32 v32, v32
  v_exp_f32 v33, v33
  v_cvt_pk_bf16_f32 v34, v32, v32
  v_cvt_pk_bf16_f32 v35, v33, v33
  v_add_f32 v17, v17, v32
  v_and_b32 v40, v34, v4
  v_and_b32 v41, v34, v5
  v_and_b32_dpp v42, v34, v6 row_half_mirror row_mask:0xf bank_mask:0xf
  v_and_b32_dpp v43, v34, v7 row_half_mirror row_mask:0xf bank_mask:0xf
  v_and_b32 v46, v34, v6
  v_and_b32 v47, v34, v7
  v_and_b32_dpp v44, v34, v4 row_half_mirror row_mask:0xf bank_mask:0xf
  v_and_b32_dpp v45, v34, v5 row_half_mirror row_mask:0xf bank_mask:0xf
  v_add_f32 v17, v17, v33
  v_and_b32 v48, v35, v4
  v_and_b32 v49, v35, v5
  v_and_b32_dpp v50, v35, v6 row_half_mirror row_mask:0xf bank_mask:0xf
  v_and_b32_dpp v51, v35, v7 row_half_mirror row_mask:0xf bank_mask:0xf
  v_and_b32 v54, v35, v6
  v_and_b32 v55, v35, v7
  v_and_b32_dpp v52, v35, v4 row_half_mirror row_mask:0xf bank_mask:0xf
  v_and_b32_dpp v53, v35, v5 row_half_mirror row_mask:0xf bank_mask:0xf
  s_waitcnt vmcnt(28)
  v_mfma_f32_16x16x32_bf16 v[20:23], v[120:123], v[40:43], v[20:23]
  v_mfma_f32_16x16x32_bf16 v[20:23], v[124:127], v[44:47], v[20:23]
  v_mfma_f32_16x16x32_bf16 v[20:23], v[128:131], v[48:51], v[20:23]
  v_mfma_f32_16x16x32_bf16 v[20:23], v[132:135], v[52:55], v[20:23]
  buffer_load_dwordx4 v[120:123], v3, s[32:35], s68 offen offset:0 nt
  buffer_load_dwordx4 v[124:127], v3, s[32:35], s68 offen offset:1024 nt
  buffer_load_dwordx4 v[128:131], v3, s[32:35], s68 offen offset:2048 nt
  buffer_load_dwordx4 v[132:135], v3, s[32:35], s68 offen offset:3072 nt
  s_waitcnt vmcnt(28)
  v_mfma_f32_16x16x32_bf16 v[24:27], v[136:139], v[8:11], 0
  v_mfma_f32_16x16x32_bf16 v[28:31], v[144:147], v[8:11], 0
  v_mfma_f32_16x16x32_bf16 v[24:27], v[140:143], v[12:15], v[24:27]
  v_mfma_f32_16x16x32_bf16 v[28:31], v[148:151], v[12:15], v[28:31]
  v_mov_b32 v32, v16
  v_mov_b32 v33, v16
  s_nop 4
  v_fmac_f32_dpp v32, v24, v18 quad_perm:[0,0,0,0] row_mask:0xf bank_mask:0xf
  v_fmac_f32_dpp v33, v28, v18 quad_perm:[0,0,0,0] row_mask:0xf bank_mask:0xf
  s_nop 0
  v_fmac_f32_dpp v32, v25, v18 quad_perm:[1,1,1,1] row_mask:0xf bank_mask:0xf
  v_fmac_f32_dpp v33, v29, v18 quad_perm:[1,1,1,1] row_mask:0xf bank_mask:0xf
  s_nop 0
  v_fmac_f32_dpp v32, v26, v18 quad_perm:[2,2,2,2] row_mask:0xf bank_mask:0xf
  v_fmac_f32_dpp v33, v30, v18 quad_perm:[2,2,2,2] row_mask:0xf bank_mask:0xf
  s_nop 0
  v_fmac_f32_dpp v32, v27, v18 quad_perm:[3,3,3,3] row_mask:0xf bank_mask:0xf
  v_fmac_f32_dpp v33, v31, v18 quad_perm:[3,3,3,3] row_mask:0xf bank_mask:0xf
  v_max_f32 v36, v32, v33
  v_cmp_lt_f32 vcc, 0, v36
  s_cbranch_vccnz L_tramp1
L_back1:
  v_exp_f32 v32, v32
  v_exp_f32 v33, v33
  v_cvt_pk_bf16_f32 v34, v32, v32
  v_cvt_pk_bf16_f32 v35, v33, v33
  v_add_f32 v17, v17, v32
  v_and_b32 v40, v34, v4
  v_and_b32 v41, v34, v5
  v_and_b32_dpp v42, v34, v6 row_half_mirror row_mask:0xf bank_mask:0xf
  v_and_b32_dpp v43, v34, v7 row_half_mirror row_mask:0xf bank_mask:0xf
  v_and_b32 v46, v34, v6
  v_and_b32 v47, v34, v7
  v_and_b32_dpp v44, v34, v4 row_half_mirror row_mask:0xf bank_mask:0xf
  v_and_b32_dpp v45, v34, v5 row_half_mirror row_mask:0xf bank_mask:0xf
  v_add_f32 v17, v17, v33
  v_and_b32 v48, v35, v4
  v_and_b32 v49, v35, v5
  v_and_b32_dpp v50, v35, v6 row_half_mirror row_mask:0xf bank_mask:0xf
  v_and_b32_dpp v51, v35, v7 row_half_mirror row_mask:0xf bank_mask:0xf
  v_and_b32 v54, v35, v6
  v_and_b32 v55, v35, v7
  v_and_b32_dpp v52, v35, v4 row_half_mirror row_mask:0xf bank_mask:0xf
  v_and_b32_dpp v53, v35, v5 row_half_mirror row_mask:0xf bank_mask:0xf
  s_waitcnt vmcnt(24)
  v_mfma_f32_16x16x32_bf16 v[20:23], v[152:155], v[40:43], v[20:23]
  v_mfma_f32_16x16x32_bf16 v[20:23], v[156:159], v[44:47], v[20:23]
  v_mfma_f32_16x16x32_bf16 v[20:23], v[160:163], v[48:51], v[20:23]
  v_mfma_f32_16x16x32_bf16 v[20:23], v[164:167], v[52:55], v[20:23]
  s_waitcnt vmcnt(20)
  v_mfma_f32_16x16x32_bf16 v[24:27], v[168:171], v[8:11], 0
  v_mfma_f32_16x16x32_bf16 v[28:31], v[176:179], v[8:11], 0
  v_mfma_f32_16x16x32_bf16 v[24:27], v[172:175], v[12:15], v[24:27]
  v_mfma_f32_16x16x32_bf16 v[28:31], v[180:183], v[12:15], v[28:31]
  v_mov_b32 v32, v16
  v_mov_b32 v33, v16
  s_nop 4
  v_fmac_f32_dpp v32, v24, v18 quad_perm:[0,0,0,0] row_mask:0xf bank_mask:0xf
  v_fmac_f32_dpp v33, v28, v18 quad_perm:[0,0,0,0] row_mask:0xf bank_mask:0xf
  s_nop 0
  v_fmac_f32_dpp v32, v25, v18 quad_perm:[1,1,1,1] row_mask:0xf bank_mask:0xf
  v_fmac_f32_dpp v33, v29, v18 quad_perm:[1,1,1,1] row_mask:0xf bank_mask:0xf
  s_nop 0
  v_fmac_f32_dpp v32, v26, v18 quad_perm:[2,2,2,2] row_mask:0xf bank_mask:0xf
  v_fmac_f32_dpp v33, v30, v18 quad_perm:[2,2,2,2] row_mask:0xf bank_mask:0xf
  s_nop 0
  v_fmac_f32_dpp v32, v27, v18 quad_perm:[3,3,3,3] row_mask:0xf bank_mask:0xf
  v_fmac_f32_dpp v33, v31, v18 quad_perm:[3,3,3,3] row_mask:0xf bank_mask:0xf
  v_max_f32 v36, v32, v33
  v_cmp_lt_f32 vcc, 0, v36
  s_cbranch_vccnz L_tramp2
L_back2:
  v_exp_f32 v32, v32
  v_exp_f32 v33, v33
  v_cvt_pk_bf16_f32 v34, v32, v32
  v_cvt_pk_bf16_f32 v35, v33, v33
  v_add_f32 v17, v17, v32
  v_and_b32 v40, v34, v4
  v_and_b32 v41, v34, v5
  v_and_b32_dpp v42, v34, v6 row_half_mirror row_mask:0xf bank_mask:0xf
  v_and_b32_dpp v43, v34, v7 row_half_mirror row_mask:0xf bank_mask:0xf
  v_and_b32 v46, v34, v6
  v_and_b32 v47, v34, v7
  v_and_b32_dpp v44, v34, v4 row_half_mirror row_mask:0xf bank_mask:0xf
  v_and_b32_dpp v45, v34, v5 row_half_mirror row_mask:0xf bank_mask:0xf
  v_add_f32 v17, v17, v33
  v_and_b32 v48, v35, v4
  v_and_b32 v49, v35, v5
  v_and_b32_dpp v50, v35, v6 row_half_mirror row_mask:0xf bank_mask:0xf
  v_and_b32_dpp v51, v35, v7 row_half_mirror row_mask:0xf bank_mask:0xf
  v_and_b32 v54, v35, v6
  v_and_b32 v55, v35, v7
  v_and_b32_dpp v52, v35, v4 row_half_mirror row_mask:0xf bank_mask:0xf
  v_and_b32_dpp v53, v35, v5 row_half_mirror row_mask:0xf bank_mask:0xf
  s_waitcnt vmcnt(16)
  v_mfma_f32_16x16x32_bf16 v[20:23], v[184:187], v[40:43], v[20:23]
  v_mfma_f32_16x16x32_bf16 v[20:23], v[188:191], v[44:47], v[20:23]
  v_mfma_f32_16x16x32_bf16 v[20:23], v[192:195], v[48:51], v[20:23]
  v_mfma_f32_16x16x32_bf16 v[20:23], v[196:199], v[52:55], v[20:23]
  s_waitcnt vmcnt(12)
  v_mfma_f32_16x16x32_bf16 v[24:27], v[200:203], v[8:11], 0
  v_mfma_f32_16x16x32_bf16 v[28:31], v[208:211], v[8:11], 0
  v_mfma_f32_16x16x32_bf16 v[24:27], v[204:207], v[12:15], v[24:27]
  v_mfma_f32_16x16x32_bf16 v[28:31], v[212:215], v[12:15], v[28:31]
  v_mov_b32 v32, v16
  v_mov_b32 v33, v16
  s_nop 4
  v_fmac_f32_dpp v32, v24, v18 quad_perm:[0,0,0,0] row_mask:0xf bank_mask:0xf
  v_fmac_f32_dpp v33, v28, v18 quad_perm:[0,0,0,0] row_mask:0xf bank_mask:0xf
  s_nop 0
  v_fmac_f32_dpp v32, v25, v18 quad_perm:[1,1,1,1] row_mask:0xf bank_mask:0xf
  v_fmac_f32_dpp v33, v29, v18 quad_perm:[1,1,1,1] row_mask:0xf bank_mask:0xf
  s_nop 0
  v_fmac_f32_dpp v32, v26, v18 quad_perm:[2,2,2,2] row_mask:0xf bank_mask:0xf
  v_fmac_f32_dpp v33, v30, v18 quad_perm:[2,2,2,2] row_mask:0xf bank_mask:0xf
  s_nop 0
  v_fmac_f32_dpp v32, v27, v18 quad_perm:[3,3,3,3] row_mask:0xf bank_mask:0xf
  v_fmac_f32_dpp v33, v31, v18 quad_perm:[3,3,3,3] row_mask:0xf bank_mask:0xf
  v_max_f32 v36, v32, v33
  v_cmp_lt_f32 vcc, 0, v36
  s_cbranch_vccnz L_tramp3
L_back3:
  v_exp_f32 v32, v32
  v_exp_f32 v33, v33
  v_cvt_pk_bf16_f32 v34, v32, v32
  v_cvt_pk_bf16_f32 v35, v33, v33
  v_add_f32 v17, v17, v32
  v_and_b32 v40, v34, v4
  v_and_b32 v41, v34, v5
  v_and_b32_dpp v42, v34, v6 row_half_mirror row_mask:0xf bank_mask:0xf
  v_and_b32_dpp v43, v34, v7 row_half_mirror row_mask:0xf bank_mask:0xf
  v_and_b32 v46, v34, v6
  v_and_b32 v47, v34, v7
  v_and_b32_dpp v44, v34, v4 row_half_mirror row_mask:0xf bank_mask:0xf
  v_and_b32_dpp v45, v34, v5 row_half_mirror row_mask:0xf bank_mask:0xf
  v_add_f32 v17, v17, v33
  v_and_b32 v48, v35, v4
  v_and_b32 v49, v35, v5
  v_and_b32_dpp v50, v35, v6 row_half_mirror row_mask:0xf bank_mask:0xf
  v_and_b32_dpp v51, v35, v7 row_half_mirror row_mask:0xf bank_mask:0xf
  v_and_b32 v54, v35, v6
  v_and_b32 v55, v35, v7
  v_and_b32_dpp v52, v35, v4 row_half_mirror row_mask:0xf bank_mask:0xf
  v_and_b32_dpp v53, v35, v5 row_half_mirror row_mask:0xf bank_mask:0xf
  s_waitcnt vmcnt(8)
  v_mfma_f32_16x16x32_bf16 v[20:23], v[216:219], v[40:43], v[20:23]
  v_mfma_f32_16x16x32_bf16 v[20:23], v[220:223], v[44:47], v[20:23]
  v_mfma_f32_16x16x32_bf16 v[20:23], v[224:227], v[48:51], v[20:23]
  v_mfma_f32_16x16x32_bf16 v[20:23], v[228:231], v[52:55], v[20:23]
  s_nop 6
L_loop:
  s_cmp_ge_u32 s68, 0x7f000000
  s_cbranch_scc1 L_drained
  s_waitcnt lgkmcnt(0)
  s_cmp_lt_u32 s61, 1024
  s_cbranch_scc0 L_notk0
  s_lshl_b32 s69, s61, 12
  s_add_u32 s69, s69, s58
  s_mov_b32 s61, 1
  s_atomic_add s61, s[26:27], 0x0 glc
L_issue0:
  buffer_load_dwordx4 v[136:139], v2, s[28:31], s69 offen offset:0 nt
  buffer_load_dwordx4 v[140:143], v2, s[28:31], s69 offen offset:1024 nt
  buffer_load_dwordx4 v[144:147], v2, s[28:31], s69 offen offset:2048 nt
  buffer_load_dwordx4 v[148:151], v2, s[28:31], s69 offen offset:3072 nt
  buffer_load_dwordx4 v[152:155], v3, s[32:35], s69 offen offset:0 nt
  buffer_load_dwordx4 v[156:159], v3, s[32:35], s69 offen offset:1024 nt
  buffer_load_dwordx4 v[160:163], v3, s[32:35], s69 offen offset:2048 nt
  buffer_load_dwordx4 v[164:167], v3, s[32:35], s69 offen offset:3072 nt
L_after0:
  s_waitcnt vmcnt(12)
  v_mfma_f32_16x16x32_bf16 v[24:27], v[104:107], v[8:11], 0
  v_mfma_f32_16x16x32_bf16 v[28:31], v[112:115], v[8:11], 0
  v_mfma_f32_16x16x32_bf16 v[24:27], v[108:111], v[12:15], v[24:27]
  v_mfma_f32_16x16x32_bf16 v[28:31], v[116:119], v[12:15], v[28:31]
  v_mov_b32 v32, v16
  v_mov_b32 v33, v16
  s_nop 4
  v_fmac_f32_dpp v32, v24, v18 quad_perm:[0,0,0,0] row_mask:0xf bank_mask:0xf
  v_fmac_f32_dpp v33, v28, v18 quad_perm:[0,0,0,0] row_mask:0xf bank_mask:0xf
  s_nop 0
  v_fmac_f32_dpp v32, v25, v18 quad_perm:[1,1,1,1] row_mask:0xf bank_mask:0xf
  v_fmac_f32_dpp v33, v29, v18 quad_perm:[1,1,1,1] row_mask:0xf bank_mask:0xf
  s_nop 0
  v_fmac_f32_dpp v32, v26, v18 quad_perm:[2,2,2,2] row_mask:0xf bank_mask:0xf
  v_fmac_f32_dpp v33, v30, v18 quad_perm:[2,2,2,2] row_mask:0xf bank_mask:0xf
  s_nop 0
  v_fmac_f32_dpp v32, v27, v18 quad_perm:[3,3,3,3] row_mask:0xf bank_mask:0xf
  v_fmac_f32_dpp v33, v31, v18 quad_perm:[3,3,3,3] row_mask:0xf bank_mask:0xf
  v_max_f32 v36, v32, v33
  v_cmp_lt_f32 vcc, 0, v36
  s_cbranch_vccnz L_tramp4
L_back4:
  v_exp_f32 v32, v32
  v_exp_f32 v33, v33
  v_cvt_pk_bf16_f32 v34, v32, v32
  v_cvt_pk_bf16_f32 v35, v33, v33
  v_add_f32 v17, v17, v32
  v_and_b32 v40, v34, v4
  v_and_b32 v41, v34, v5
  v_and_b32_dpp v42, v34, v6 row_half_mirror row_mask:0xf bank_mask:0xf
  v_and_b32_dpp v43, v34, v7 row_half_mirror row_mask:0xf bank_mask:0xf
  v_and_b32 v46, v34, v6
  v_and_b32 v47, v34, v7
  v_and_b32_dpp v44, v34, v4 row_half_mirror row_mask:0xf bank_mask:0xf
  v_and_b32_dpp v45, v34, v5 row_half_mirror row_mask:0xf bank_mask:0xf
  v_add_f32 v17, v17, v33
  v_and_b32 v48, v35, v4
  v_and_b32 v49, v35, v5
  v_and_b32_dpp v50, v35, v6 row_half_mirror row_mask:0xf bank_mask:0xf
  v_and_b32_dpp v51, v35, v7 row_half_mirror row_mask:0xf bank_mask:0xf
  v_and_b32 v54, v35, v6
  v_and_b32 v55, v35, v7
  v_and_b32_dpp v52, v35, v4 row_half_mirror row_mask:0xf bank_mask:0xf
  v_and_b32_dpp v53, v35, v5 row_half_mirror row_mask:0xf bank_mask:0xf
  s_waitcnt vmcnt(8)
  v_mfma_f32_16x16x32_bf16 v[20:23], v[120:123], v[40:43], v[20:23]
  v_mfma_f32_16x16x32_bf16 v[20:23], v[124:127], v[44:47], v[20:23]
  v_mfma_f32_16x16x32_bf16 v[20:23], v[128:131], v[48:51], v[20:23]
  v_mfma_f32_16x16x32_bf16 v[20:23], v[132:135], v[52:55], v[20:23]
  s_cmp_ge_u32 s69, 0x7f000000
  s_nop 5
  s_cbranch_scc1 L_drained
  s_waitcnt lgkmcnt(0)
  s_cmp_lt_u32 s61, 1024
  s_cbranch_scc0 L_notk1
  s_lshl_b32 s70, s61, 12
  s_add_u32 s70, s70, s58
  s_mov_b32 s61, 1
  s_atomic_add s61, s[26:27], 0x0 glc
L_issue1:
  buffer_load_dwordx4 v[168:171], v2, s[28:31], s70 offen offset:0 nt
  buffer_load_dwordx4 v[172:175], v2, s[28:31], s70 offen offset:1024 nt
  buffer_load_dwordx4 v[176:179], v2, s[28:31], s70 offen offset:2048 nt
  buffer_load_dwordx4 v[180:183], v2, s[28:31], s70 offen offset:3072 nt
  buffer_load_dwordx4 v[184:187], v3, s[32:35], s70 offen offset:0 nt
  buffer_load_dwordx4 v[188:191], v3, s[32:35], s70 offen offset:1024 nt
  buffer_load_dwordx4 v[192:195], v3, s[32:35], s70 offen offset:2048 nt
  buffer_load_dwordx4 v[196:199], v3, s[32:35], s70 offen offset:3072 nt
L_after1:
  s_waitcnt vmcnt(12)
  v_mfma_f32_16x16x32_bf16 v[24:27], v[136:139], v[8:11], 0
  v_mfma_f32_16x16x32_bf16 v[28:31], v[144:147], v[8:11], 0
  v_mfma_f32_16x16x32_bf16 v[24:27], v[140:143], v[12:15], v[24:27]
  v_mfma_f32_16x16x32_bf16 v[28:31], v[148:151], v[12:15], v[28:31]
  v_mov_b32 v32, v16
  v_mov_b32 v33, v16
  s_nop 4
  v_fmac_f32_dpp v32, v24, v18 quad_perm:[0,0,0,0] row_mask:0xf bank_mask:0xf
  v_fmac_f32_dpp v33, v28, v18 quad_perm:[0,0,0,0] row_mask:0xf bank_mask:0xf
  s_nop 0
  v_fmac_f32_dpp v32, v25, v18 quad_perm:[1,1,1,1] row_mask:0xf bank_mask:0xf
  v_fmac_f32_dpp v33, v29, v18 quad_perm:[1,1,1,1] row_mask:0xf bank_mask:0xf
  s_nop 0
  v_fmac_f32_dpp v32, v26, v18 quad_perm:[2,2,2,2] row_mask:0xf bank_mask:0xf
  v_fmac_f32_dpp v33, v30, v18 quad_perm:[2,2,2,2] row_mask:0xf bank_mask:0xf
  s_nop 0
  v_fmac_f32_dpp v32, v27, v18 quad_perm:[3,3,3,3] row_mask:0xf bank_mask:0xf
  v_fmac_f32_dpp v33, v31, v18 quad_perm:[3,3,3,3] row_mask:0xf bank_mask:0xf
  v_max_f32 v36, v32, v33
  v_cmp_lt_f32 vcc, 0, v36
  s_cbranch_vccnz L_tramp5
L_back5:
  v_exp_f32 v32, v32
  v_exp_f32 v33, v33
  v_cvt_pk_bf16_f32 v34, v32, v32
  v_cvt_pk_bf16_f32 v35, v33, v33
  v_add_f32 v17, v17, v32
  v_and_b32 v40, v34, v4
  v_and_b32 v41, v34, v5
  v_and_b32_dpp v42, v34, v6 row_half_mirror row_mask:0xf bank_mask:0xf
  v_and_b32_dpp v43, v34, v7 row_half_mirror row_mask:0xf bank_mask:0xf
  v_and_b32 v46, v34, v6
  v_and_b32 v47, v34, v7
  v_and_b32_dpp v44, v34, v4 row_half_mirror row_mask:0xf bank_mask:0xf
  v_and_b32_dpp v45, v34, v5 row_half_mirror row_mask:0xf bank_mask:0xf
  v_add_f32 v17, v17, v33
  v_and_b32 v48, v35, v4
  v_and_b32 v49, v35, v5
  v_and_b32_dpp v50, v35, v6 row_half_mirror row_mask:0xf bank_mask:0xf
  v_and_b32_dpp v51, v35, v7 row_half_mirror row_mask:0xf bank_mask:0xf
  v_and_b32 v54, v35, v6
  v_and_b32 v55, v35, v7
  v_and_b32_dpp v52, v35, v4 row_half_mirror row_mask:0xf bank_mask:0xf
  v_and_b32_dpp v53, v35, v5 row_half_mirror row_mask:0xf bank_mask:0xf
  s_waitcnt vmcnt(8)
  v_mfma_f32_16x16x32_bf16 v[20:23], v[152:155], v[40:43], v[20:23]
  v_mfma_f32_16x16x32_bf16 v[20:23], v[156:159], v[44:47], v[20:23]
  v_mfma_f32_16x16x32_bf16 v[20:23], v[160:163], v[48:51], v[20:23]
  v_mfma_f32_16x16x32_bf16 v[20:23], v[164:167], v[52:55], v[20:23]
  s_cmp_ge_u32 s70, 0x7f000000
  s_nop 5
  s_cbranch_scc1 L_drained
  s_waitcnt lgkmcnt(0)
  s_cmp_lt_u32 s61, 1024
  s_cbranch_scc0 L_notk2
  s_lshl_b32 s71, s61, 12
  s_add_u32 s71, s71, s58
  s_mov_b32 s61, 1
  s_atomic_add s61, s[26:27], 0x0 glc
L_issue2:
  buffer_load_dwordx4 v[200:203], v2, s[28:31], s71 offen offset:0 nt
  buffer_load_dwordx4 v[204:207], v2, s[28:31], s71 offen offset:1024 nt
  buffer_load_dwordx4 v[208:211], v2, s[28:31], s71 offen offset:2048 nt
  buffer_load_dwordx4 v[212:215], v2, s[28:31], s71 offen offset:3072 nt
  buffer_load_dwordx4 v[216:219], v3, s[32:35], s71 offen offset:0 nt
  buffer_load_dwordx4 v[220:223], v3, s[32:35], s71 offen offset:1024 nt
  buffer_load_dwordx4 v[224:227], v3, s[32:35], s71 offen offset:2048 nt
  buffer_load_dwordx4 v[228:231], v3, s[32:35], s71 offen offset:3072 nt
L_after2:
  s_waitcnt vmcnt(12)
  v_mfma_f32_16x16x32_bf16 v[24:27], v[168:171], v[8:11], 0
  v_mfma_f32_16x16x32_bf16 v[28:31], v[176:179], v[8:11], 0
  v_mfma_f32_16x16x32_bf16 v[24:27], v[172:175], v[12:15], v[24:27]
  v_mfma_f32_16x16x32_bf16 v[28:31], v[180:183], v[12:15], v[28:31]
  v_mov_b32 v32, v16
  v_mov_b32 v33, v16
  s_nop 4
  v_fmac_f32_dpp v32, v24, v18 quad_perm:[0,0,0,0] row_mask:0xf bank_mask:0xf
  v_fmac_f32_dpp v33, v28, v18 quad_perm:[0,0,0,0] row_mask:0xf bank_mask:0xf
  s_nop 0
  v_fmac_f32_dpp v32, v25, v18 quad_perm:[1,1,1,1] row_mask:0xf bank_mask:0xf
  v_fmac_f32_dpp v33, v29, v18 quad_perm:[1,1,1,1] row_mask:0xf bank_mask:0xf
  s_nop 0
  v_fmac_f32_dpp v32, v26, v18 quad_perm:[2,2,2,2] row_mask:0xf bank_mask:0xf
  v_fmac_f32_dpp v33, v30, v18 quad_perm:[2,2,2,2] row_mask:0xf bank_mask:0xf
  s_nop 0
  v_fmac_f32_dpp v32, v27, v18 quad_perm:[3,3,3,3] row_mask:0xf bank_mask:0xf
  v_fmac_f32_dpp v33, v31, v18 quad_perm:[3,3,3,3] row_mask:0xf bank_mask:0xf
  v_max_f32 v36, v32, v33
  v_cmp_lt_f32 vcc, 0, v36
  s_cbranch_vccnz L_tramp6
L_back6:
  v_exp_f32 v32, v32
  v_exp_f32 v33, v33
  v_cvt_pk_bf16_f32 v34, v32, v32
  v_cvt_pk_bf16_f32 v35, v33, v33
  v_add_f32 v17, v17, v32
  v_and_b32 v40, v34, v4
  v_and_b32 v41, v34, v5
  v_and_b32_dpp v42, v34, v6 row_half_mirror row_mask:0xf bank_mask:0xf
  v_and_b32_dpp v43, v34, v7 row_half_mirror row_mask:0xf bank_mask:0xf
  v_and_b32 v46, v34, v6
  v_and_b32 v47, v34, v7
  v_and_b32_dpp v44, v34, v4 row_half_mirror row_mask:0xf bank_mask:0xf
  v_and_b32_dpp v45, v34, v5 row_half_mirror row_mask:0xf bank_mask:0xf
  v_add_f32 v17, v17, v33
  v_and_b32 v48, v35, v4
  v_and_b32 v49, v35, v5
  v_and_b32_dpp v50, v35, v6 row_half_mirror row_mask:0xf bank_mask:0xf
  v_and_b32_dpp v51, v35, v7 row_half_mirror row_mask:0xf bank_mask:0xf
  v_and_b32 v54, v35, v6
  v_and_b32 v55, v35, v7
  v_and_b32_dpp v52, v35, v4 row_half_mirror row_mask:0xf bank_mask:0xf
  v_and_b32_dpp v53, v35, v5 row_half_mirror row_mask:0xf bank_mask:0xf
  s_waitcnt vmcnt(8)
  v_mfma_f32_16x16x32_bf16 v[20:23], v[184:187], v[40:43], v[20:23]
  v_mfma_f32_16x16x32_bf16 v[20:23], v[188:191], v[44:47], v[20:23]
  v_mfma_f32_16x16x32_bf16 v[20:23], v[192:195], v[48:51], v[20:23]
  v_mfma_f32_16x16x32_bf16 v[20:23], v[196:199], v[52:55], v[20:23]
  s_cmp_ge_u32 s71, 0x7f000000
  s_nop 5
  s_cbranch_scc1 L_drained
  s_waitcnt lgkmcnt(0)
  s_cmp_lt_u32 s61, 1024
  s_cbranch_scc0 L_notk3
  s_lshl_b32 s68, s61, 12
  s_add_u32 s68, s68, s58
  s_mov_b32 s61, 1
  s_atomic_add s61, s[26:27], 0x0 glc
L_issue3:
  buffer_load_dwordx4 v[104:107], v2, s[28:31], s68 offen offset:0 nt
  buffer_load_dwordx4 v[108:111], v2, s[28:31], s68 offen offset:1024 nt
  buffer_load_dwordx4 v[112:115], v2, s[28:31], s68 offen offset:2048 nt
  buffer_load_dwordx4 v[116:119], v2, s[28:31], s68 offen offset:3072 nt
  buffer_load_dwordx4 v[120:123], v3, s[32:35], s68 offen offset:0 nt
  buffer_load_dwordx4 v[124:127], v3, s[32:35], s68 offen offset:1024 nt
  buffer_load_dwordx4 v[128:131], v3, s[32:35], s68 offen offset:2048 nt
  buffer_load_dwordx4 v[132:135], v3, s[32:35], s68 offen offset:3072 nt
L_after3:
  s_waitcnt vmcnt(12)
  v_mfma_f32_16x16x32_bf16 v[24:27], v[200:203], v[8:11], 0
  v_mfma_f32_16x16x32_bf16 v[28:31], v[208:211], v[8:11], 0
  v_mfma_f32_16x16x32_bf16 v[24:27], v[204:207], v[12:15], v[24:27]
  v_mfma_f32_16x16x32_bf16 v[28:31], v[212:215], v[12:15], v[28:31]
  v_mov_b32 v32, v16
  v_mov_b32 v33, v16
  s_nop 4
  v_fmac_f32_dpp v32, v24, v18 quad_perm:[0,0,0,0] row_mask:0xf bank_mask:0xf
  v_fmac_f32_dpp v33, v28, v18 quad_perm:[0,0,0,0] row_mask:0xf bank_mask:0xf
  s_nop 0
  v_fmac_f32_dpp v32, v25, v18 quad_perm:[1,1,1,1] row_mask:0xf bank_mask:0xf
  v_fmac_f32_dpp v33, v29, v18 quad_perm:[1,1,1,1] row_mask:0xf bank_mask:0xf
  s_nop 0
  v_fmac_f32_dpp v32, v26, v18 quad_perm:[2,2,2,2] row_mask:0xf bank_mask:0xf
  v_fmac_f32_dpp v33, v30, v18 quad_perm:[2,2,2,2] row_mask:0xf bank_mask:0xf
  s_nop 0
  v_fmac_f32_dpp v32, v27, v18 quad_perm:[3,3,3,3] row_mask:0xf bank_mask:0xf
  v_fmac_f32_dpp v33, v31, v18 quad_perm:[3,3,3,3] row_mask:0xf bank_mask:0xf
  v_max_f32 v36, v32, v33
  v_cmp_lt_f32 vcc, 0, v36
  s_cbranch_vccnz L_tramp7
L_back7:
  v_exp_f32 v32, v32
  v_exp_f32 v33, v33
  v_cvt_pk_bf16_f32 v34, v32, v32
  v_cvt_pk_bf16_f32 v35, v33, v33
  v_add_f32 v17, v17, v32
  v_and_b32 v40, v34, v4
  v_and_b32 v41, v34, v5
  v_and_b32_dpp v42, v34, v6 row_half_mirror row_mask:0xf bank_mask:0xf
  v_and_b32_dpp v43, v34, v7 row_half_mirror row_mask:0xf bank_mask:0xf
  v_and_b32 v46, v34, v6
  v_and_b32 v47, v34, v7
  v_and_b32_dpp v44, v34, v4 row_half_mirror row_mask:0xf bank_mask:0xf
  v_and_b32_dpp v45, v34, v5 row_half_mirror row_mask:0xf bank_mask:0xf
  v_add_f32 v17, v17, v33
  v_and_b32 v48, v35, v4
  v_and_b32 v49, v35, v5
  v_and_b32_dpp v50, v35, v6 row_half_mirror row_mask:0xf bank_mask:0xf
  v_and_b32_dpp v51, v35, v7 row_half_mirror row_mask:0xf bank_mask:0xf
  v_and_b32 v54, v35, v6
  v_and_b32 v55, v35, v7
  v_and_b32_dpp v52, v35, v4 row_half_mirror row_mask:0xf bank_mask:0xf
  v_and_b32_dpp v53, v35, v5 row_half_mirror row_mask:0xf bank_mask:0xf
  s_waitcnt vmcnt(8)
  v_mfma_f32_16x16x32_bf16 v[20:23], v[216:219], v[40:43], v[20:23]
  v_mfma_f32_16x16x32_bf16 v[20:23], v[220:223], v[44:47], v[20:23]
  v_mfma_f32_16x16x32_bf16 v[20:23], v[224:227], v[48:51], v[20:23]
  v_mfma_f32_16x16x32_bf16 v[20:23], v[228:231], v[52:55], v[20:23]
  s_nop 6
  s_branch L_loop
L_drained:
  s_call_b64 s[18:19], L_wo
  v_add_f32_dpp v17, v17, v17 row_half_mirror row_mask:0xf bank_mask:0xf
  ds_write_b128 v244, v[20:23] offset:3072
  v_mov_b32 v36, v17
  s_nop 1
  v_permlane16_swap_b32 v17, v36
  v_add_f32 v17, v17, v36
  v_mov_b32 v36, v17
  s_nop 1
  v_permlane32_swap_b32 v17, v36
  v_add_f32 v17, v17, v36
  ds_write_b64 v245, v[16:17] offset:7168
  s_mov_b64 s[64:65], -1
  s_cmp_eq_u32 s6, 3
  s_waitcnt lgkmcnt(0)
  s_barrier
  s_cbranch_scc1 L_w3
L_poll1:
  s_mov_b64 exec, s[64:65]
  buffer_load_dwordx4 v[104:107], v246, s[52:55], s9 offen sc1
  buffer_load_dwordx4 v[108:111], v246, s[52:55], s9 offen offset:16 sc1
  buffer_load_dwordx4 v[112:115], v247, s[52:55], s10 offen offset:2048 sc1
  s_sub_u32 s62, s62, 1
  s_cbranch_scc1 L_end
  s_waitcnt vmcnt(0)
  v_xor_b32 v105, s56, v105
  v_xor_b32 v107, s57, v107
  v_xor_b32 v109, s56, v109
  v_xor_b32 v111, s57, v111
  v_xor_b32 v113, s56, v113
  v_xor_b32 v115, s57, v115
  v_or_b32 v36, v105, v107
  v_or3_b32 v36, v109, v111, v36
  v_or3_b32 v36, v113, v115, v36
  v_cmp_ne_u32_e64 s[64:65], 0, v36
  s_cmp_eq_u64 s[64:65], 0
  s_nop 2
  s_cbranch_scc0 L_poll1
  s_mov_b64 exec, -1
  v_min_f32_dpp v36, v112, v112 quad_perm:[1,0,3,2] row_mask:0xf bank_mask:0xf
  s_nop 1
  v_min_f32_dpp v36, v36, v36 quad_perm:[2,3,0,1] row_mask:0xf bank_mask:0xf
  s_nop 1
  v_min_f32_dpp v36, v36, v36 row_half_mirror row_mask:0xf bank_mask:0xf
  v_sub_f32 v36, v36, v112
  v_exp_f32 v36, v36
  s_nop 0
  v_mul_f32 v114, v114, v36
  v_mul_f32 v104, v104, v36
  v_mul_f32 v106, v106, v36
  v_mul_f32 v108, v108, v36
  v_mul_f32 v110, v110, v36
  v_add_f32_dpp v114, v114, v114 quad_perm:[1,0,3,2] row_mask:0xf bank_mask:0xf
  v_add_f32_dpp v104, v104, v104 quad_perm:[1,0,3,2] row_mask:0xf bank_mask:0xf
  v_add_f32_dpp v106, v106, v106 quad_perm:[1,0,3,2] row_mask:0xf bank_mask:0xf
  v_add_f32_dpp v108, v108, v108 quad_perm:[1,0,3,2] row_mask:0xf bank_mask:0xf
  v_add_f32_dpp v110, v110, v110 quad_perm:[1,0,3,2] row_mask:0xf bank_mask:0xf
  v_add_f32_dpp v114, v114, v114 quad_perm:[2,3,0,1] row_mask:0xf bank_mask:0xf
  v_add_f32_dpp v104, v104, v104 quad_perm:[2,3,0,1] row_mask:0xf bank_mask:0xf
  v_add_f32_dpp v106, v106, v106 quad_perm:[2,3,0,1] row_mask:0xf bank_mask:0xf
  v_add_f32_dpp v108, v108, v108 quad_perm:[2,3,0,1] row_mask:0xf bank_mask:0xf
  v_add_f32_dpp v110, v110, v110 quad_perm:[2,3,0,1] row_mask:0xf bank_mask:0xf
  v_add_f32_dpp v114, v114, v114 row_half_mirror row_mask:0xf bank_mask:0xf
  v_add_f32_dpp v104, v104, v104 row_half_mirror row_mask:0xf bank_mask:0xf
  v_add_f32_dpp v106, v106, v106 row_half_mirror row_mask:0xf bank_mask:0xf
  v_add_f32_dpp v108, v108, v108 row_half_mirror row_mask:0xf bank_mask:0xf
  v_add_f32_dpp v110, v110, v110 row_half_mirror row_mask:0xf bank_mask:0xf
  v_rcp_f32 v36, v114
  s_nop 0
  v_mul_f32 v104, v104, v36
  v_mul_f32 v106, v106, v36
  v_mul_f32 v108, v108, v36
  v_mul_f32 v110, v110, v36
  v_cvt_pk_bf16_f32 v104, v104, v104
  v_cvt_pk_bf16_f32 v106, v106, v106
  v_cvt_pk_bf16_f32 v108, v108, v108
  v_cvt_pk_bf16_f32 v110, v110, v110
  v_and_b32 v40, v104, v4
  v_and_b32 v41, v104, v5
  v_and_b32 v42, v104, v6
  v_and_b32 v43, v104, v7
  v_and_b32 v44, v106, v4
  v_and_b32 v45, v106, v5
  v_and_b32 v46, v106, v6
  v_and_b32 v47, v106, v7
  v_and_b32 v48, v108, v4
  v_and_b32 v49, v108, v5
  v_and_b32 v50, v108, v6
  v_and_b32 v51, v108, v7
  v_and_b32 v52, v110, v4
  v_and_b32 v53, v110, v5
  v_and_b32 v54, v110, v6
  v_and_b32 v55, v110, v7
  v_mfma_f32_16x16x32_bf16 v[120:123], v[56:59], v[40:43], 0
  v_mfma_f32_16x16x32_bf16 v[124:127], v[72:75], v[40:43], 0
  v_mfma_f32_16x16x32_bf16 v[128:131], v[88:91], v[40:43], 0
  v_mfma_f32_16x16x32_bf16 v[120:123], v[60:63], v[44:47], v[120:123]
  v_mfma_f32_16x16x32_bf16 v[124:127], v[76:79], v[44:47], v[124:127]
  v_mfma_f32_16x16x32_bf16 v[128:131], v[92:95], v[44:47], v[128:131]
  v_mfma_f32_16x16x32_bf16 v[120:123], v[64:67], v[48:51], v[120:123]
  v_mfma_f32_16x16x32_bf16 v[124:127], v[80:83], v[48:51], v[124:127]
  v_mfma_f32_16x16x32_bf16 v[128:131], v[96:99], v[48:51], v[128:131]
  v_mfma_f32_16x16x32_bf16 v[120:123], v[68:71], v[52:55], v[120:123]
  v_mfma_f32_16x16x32_bf16 v[124:127], v[84:87], v[52:55], v[124:127]
  v_mfma_f32_16x16x32_bf16 v[128:131], v[100:103], v[52:55], v[128:131]
  s_nop 5
  v_permlane32_swap_b32 v120, v121
  v_permlane32_swap_b32 v122, v123
  v_permlane32_swap_b32 v124, v125
  v_permlane32_swap_b32 v126, v127
  v_permlane32_swap_b32 v128, v129
  v_permlane32_swap_b32 v130, v131
  v_add_f32_dpp v120, v121, v120 row_ror:8 row_mask:0xf bank_mask:0xf
  v_add_f32_dpp v122, v123, v122 row_ror:8 row_mask:0xf bank_mask:0xf
  v_add_f32_dpp v124, v125, v124 row_ror:8 row_mask:0xf bank_mask:0xf
  v_add_f32_dpp v126, v127, v126 row_ror:8 row_mask:0xf bank_mask:0xf
  v_add_f32_dpp v128, v129, v128 row_ror:8 row_mask:0xf bank_mask:0xf
  v_add_f32_dpp v130, v131, v130 row_ror:8 row_mask:0xf bank_mask:0xf
  v_mov_b32 v121, s56
  v_mov_b32 v123, s57
  v_mov_b32 v125, s56
  v_mov_b32 v127, s57
  v_mov_b32 v129, s56
  v_mov_b32 v131, s57
  s_mov_b32 exec_lo, 0x00ff00ff
  s_mov_b32 exec_hi, 0x00ff00ff
  buffer_store_dwordx4 v[120:123], v248, s[52:55], s11 offen sc1
  buffer_store_dwordx4 v[124:127], v248, s[52:55], s12 offen sc1
  buffer_store_dwordx4 v[128:131], v248, s[52:55], s13 offen sc1
  s_endpgm
L_w3:
  s_waitcnt vmcnt(0)
  ds_read_b64 v[120:121], v250 offset:7168
  ds_read_b64 v[122:123], v250 offset:7184
  ds_read_b64 v[124:125], v250 offset:7200
  ds_read_b64 v[126:127], v250 offset:7216
  ds_read_b128 v[104:107], v249 offset:3072
  ds_read_b128 v[108:111], v249 offset:4096
  ds_read_b128 v[112:115], v249 offset:5120
  ds_read_b128 v[116:119], v249 offset:6144
  v_mov_b32 v129, s56
  v_mov_b32 v131, s57
  v_mov_b32 v133, s56
  v_mov_b32 v135, s57
  v_mov_b32 v137, s56
  v_mov_b32 v139, s57
  s_waitcnt lgkmcnt(4)
  v_min_f32 v136, v120, v122
  v_min3_f32 v136, v136, v124, v126
  v_sub_f32 v120, v136, v120
  v_sub_f32 v122, v136, v122
  v_sub_f32 v124, v136, v124
  v_sub_f32 v126, v136, v126
  v_exp_f32 v120, v120
  v_exp_f32 v122, v122
  v_exp_f32 v124, v124
  v_exp_f32 v126, v126
  v_mul_f32 v138, v120, v121
  v_fmac_f32 v138, v122, v123
  v_fmac_f32 v138, v124, v125
  v_fmac_f32 v138, v126, v127
  s_waitcnt lgkmcnt(0)
  v_mul_f32 v128, v104, v120
  v_mul_f32 v130, v105, v120
  v_mul_f32 v132, v106, v120
  v_mul_f32 v134, v107, v120
  v_fmac_f32 v128, v108, v122
  v_fmac_f32 v130, v109, v122
  v_fmac_f32 v132, v110, v122
  v_fmac_f32 v134, v111, v122
  v_fmac_f32 v128, v112, v124
  v_fmac_f32 v130, v113, v124
  v_fmac_f32 v132, v114, v124
  v_fmac_f32 v134, v115, v124
  v_fmac_f32 v128, v116, v126
  v_fmac_f32 v130, v117, v126
  v_fmac_f32 v132, v118, v126
  v_fmac_f32 v134, v119, v126
  buffer_store_dwordx4 v[128:131], v251, s[52:55], s8 offen sc1
  buffer_store_dwordx4 v[132:135], v251, s[52:55], s8 offen offset:16 sc1
  s_mov_b64 exec, 0x101
  buffer_store_dwordx4 v[136:139], v252, s[52:55], s8 offen offset:2048 sc1
  s_mov_b64 exec, -1
  s_cmp_ge_u32 s63, 72
  s_cbranch_scc1 L_fin
L_poll2:
  s_mov_b64 exec, s[64:65]
  buffer_load_dwordx4 v[144:147], v249, s[52:55], s14 offen offset:0 sc1
  buffer_load_dwordx4 v[148:151], v249, s[52:55], s14 offen offset:1024 sc1
  buffer_load_dwordx4 v[152:155], v249, s[52:55], s14 offen offset:2048 sc1
  buffer_load_dwordx4 v[156:159], v249, s[52:55], s14 offen offset:3072 sc1
  buffer_load_dwordx4 v[160:163], v249, s[52:55], s15 offen offset:0 sc1
  buffer_load_dwordx4 v[164:167], v249, s[52:55], s15 offen offset:1024 sc1
  buffer_load_dwordx4 v[168:171], v249, s[52:55], s15 offen offset:2048 sc1
  buffer_load_dwordx4 v[172:175], v249, s[52:55], s15 offen offset:3072 sc1
  s_sub_u32 s62, s62, 1
  s_cbranch_scc1 L_end
  s_waitcnt vmcnt(0)
  v_xor_b32 v145, s56, v145
  v_xor_b32 v147, s57, v147
  v_xor_b32 v149, s56, v149
  v_xor_b32 v151, s57, v151
  v_xor_b32 v153, s56, v153
  v_xor_b32 v155, s57, v155
  v_xor_b32 v157, s56, v157
  v_xor_b32 v159, s57, v159
  v_xor_b32 v161, s56, v161
  v_xor_b32 v163, s57, v163
  v_xor_b32 v165, s56, v165
  v_xor_b32 v167, s57, v167
  v_xor_b32 v169, s56, v169
  v_xor_b32 v171, s57, v171
  v_xor_b32 v173, s56, v173
  v_xor_b32 v175, s57, v175
  v_or_b32 v36, v145, v147
  v_or3_b32 v36, v149, v151, v36
  v_or3_b32 v36, v153, v155, v36
  v_or3_b32 v36, v157, v159, v36
  v_or3_b32 v36, v161, v163, v36
  v_or3_b32 v36, v165, v167, v36
  v_or3_b32 v36, v169, v171, v36
  v_or3_b32 v36, v173, v175, v36
  v_cmp_ne_u32_e64 s[64:65], 0, v36
  s_cmp_eq_u64 s[64:65], 0
  s_nop 2
  s_cbranch_scc1 L_h2done
  s_bcnt1_i32_b64 s72, s[64:65]
  s_cmp_lt_u32 s72, 24
  s_cbranch_scc1 L_poll2
  s_sleep 4
  s_branch L_poll2
L_h2done:
  s_mov_b64 exec, -1
  v_add_f32 v144, v144, v160
  v_add_f32 v146, v146, v162
  v_add_f32 v148, v148, v164
  v_add_f32 v150, v150, v166
  v_add_f32 v152, v152, v168
  v_add_f32 v154, v154, v170
  v_add_f32 v156, v156, v172
  v_add_f32 v158, v158, v174
  v_add_f32 v144, v144, v152
  v_add_f32 v146, v146, v154
  v_add_f32 v148, v148, v156
  v_add_f32 v150, v150, v158
  v_add_f32 v144, v144, v148
  v_add_f32 v146, v146, v150
  s_nop 0
  v_add_f32_dpp v144, v144, v144 row_ror:4 row_mask:0xf bank_mask:0xf
  v_add_f32_dpp v146, v146, v146 row_ror:4 row_mask:0xf bank_mask:0xf
  s_nop 0
  v_add_f32_dpp v144, v144, v144 row_ror:8 row_mask:0xf bank_mask:0xf
  v_add_f32_dpp v146, v146, v146 row_ror:8 row_mask:0xf bank_mask:0xf
  v_mov_b32 v145, v144
  v_mov_b32 v147, v146
  s_nop 0
  v_permlane16_swap_b32 v144, v145
  v_permlane16_swap_b32 v146, v147
  v_add_f32 v144, v144, v145
  v_add_f32 v146, v146, v147
  v_mov_b32 v145, v144
  v_mov_b32 v147, v146
  s_nop 0
  v_permlane32_swap_b32 v144, v145
  v_permlane32_swap_b32 v146, v147
  v_add_f32 v144, v144, v145
  v_add_f32 v146, v146, v147
  v_cvt_pk_bf16_f32 v144, v144, v146
  s_mov_b64 exec, 0xf
  buffer_store_short v144, v253, s[48:51], s16 offen
  buffer_store_short_d16_hi v144, v253, s[48:51], s16 offen offset:32
  s_cmp_lg_u32 s63, 0
  s_mov_b64 exec, 1
  s_cbranch_scc1 L_fin
  v_mov_b32 v148, s56
  v_mov_b32 v149, s57
  buffer_store_dwordx2 v[148:149], v255, s[52:55], s17 offen sc1
L_fin:
L_end:
  s_endpgm
L_tramp0:
  s_call_b64 s[18:19], L_rare
  s_branch L_back0
L_tramp1:
  s_call_b64 s[18:19], L_rare
  s_branch L_back1
L_tramp2:
  s_call_b64 s[18:19], L_rare
  s_branch L_back2
L_tramp3:
  s_call_b64 s[18:19], L_rare
  s_branch L_back3
L_tramp4:
  s_call_b64 s[18:19], L_rare
  s_branch L_back4
L_tramp5:
  s_call_b64 s[18:19], L_rare
  s_branch L_back5
L_tramp6:
  s_call_b64 s[18:19], L_rare
  s_branch L_back6
L_tramp7:
  s_call_b64 s[18:19], L_rare
  s_branch L_back7
L_notk0:
  s_mov_b32 s69, 0x7f000000
  s_cmp_ge_u32 s59, 2
  s_cbranch_scc1 L_issue0
  s_call_b64 s[18:19], L_wo
  s_branch L_after0
L_notk1:
  s_mov_b32 s70, 0x7f000000
  s_cmp_ge_u32 s59, 2
  s_cbranch_scc1 L_issue1
  s_call_b64 s[18:19], L_wo
  s_branch L_after1
L_notk2:
  s_mov_b32 s71, 0x7f000000
  s_cmp_ge_u32 s59, 2
  s_cbranch_scc1 L_issue2
  s_call_b64 s[18:19], L_wo
  s_branch L_after2
L_notk3:
  s_mov_b32 s68, 0x7f000000
  s_cmp_ge_u32 s59, 2
  s_cbranch_scc1 L_issue3
  s_call_b64 s[18:19], L_wo
  s_branch L_after3
L_wo:
  s_cmp_eq_u32 s59, 0
  s_cbranch_scc0 L_woB
  s_mov_b32 s59, 1
  buffer_load_dwordx4 v[56:59], v254, s[40:43], s60 offen offset:0 nt
  buffer_load_dwordx4 v[72:75], v254, s[40:43], s60 offen offset:128 nt
  buffer_load_dwordx4 v[88:91], v254, s[40:43], s60 offen offset:256 nt
  s_add_u32 s60, s60, 9216
  buffer_load_dwordx4 v[60:63], v254, s[40:43], s60 offen offset:0 nt
  buffer_load_dwordx4 v[76:79], v254, s[40:43], s60 offen offset:128 nt
  buffer_load_dwordx4 v[92:95], v254, s[40:43], s60 offen offset:256 nt
  s_add_u32 s60, s60, 9216
  buffer_load_dwordx4 v[64:67], v254, s[40:43], s60 offen offset:0 nt
  buffer_load_dwordx4 v[80:83], v254, s[40:43], s60 offen offset:128 nt
  s_setpc_b64 s[18:19]
L_woB:
  s_mov_b32 s59, 2
  buffer_load_dwordx4 v[96:99], v254, s[40:43], s60 offen offset:256 nt
  s_add_u32 s60, s60, 9216
  buffer_load_dwordx4 v[68:71], v254, s[40:43], s60 offen offset:0 nt
  buffer_load_dwordx4 v[84:87], v254, s[40:43], s60 offen offset:128 nt
  buffer_load_dwordx4 v[100:103], v254, s[40:43], s60 offen offset:256 nt
  s_mov_b32 s72, 0x7f000000
  buffer_load_dwordx4 v[232:235], v255, s[40:43], s72 offen
  buffer_load_dwordx4 v[232:235], v255, s[40:43], s72 offen
  buffer_load_dwordx4 v[232:235], v255, s[40:43], s72 offen
  buffer_load_dwordx4 v[232:235], v255, s[40:43], s72 offen
  s_setpc_b64 s[18:19]
L_rare:
  s_nop 1
  v_mul_f32_dpp v32, v24, v18 quad_perm:[0,0,0,0] row_mask:0xf bank_mask:0xf
  v_mul_f32_dpp v33, v28, v18 quad_perm:[0,0,0,0] row_mask:0xf bank_mask:0xf
  s_nop 0
  v_fmac_f32_dpp v32, v25, v18 quad_perm:[1,1,1,1] row_mask:0xf bank_mask:0xf
  v_fmac_f32_dpp v33, v29, v18 quad_perm:[1,1,1,1] row_mask:0xf bank_mask:0xf
  s_nop 0
  v_fmac_f32_dpp v32, v26, v18 quad_perm:[2,2,2,2] row_mask:0xf bank_mask:0xf
  v_fmac_f32_dpp v33, v30, v18 quad_perm:[2,2,2,2] row_mask:0xf bank_mask:0xf
  s_nop 0
  v_fmac_f32_dpp v32, v27, v18 quad_perm:[3,3,3,3] row_mask:0xf bank_mask:0xf
  v_fmac_f32_dpp v33, v31, v18 quad_perm:[3,3,3,3] row_mask:0xf bank_mask:0xf
  v_max_f32 v36, v32, v33
  s_nop 1
  v_max_f32_dpp v36, v36, v36 row_half_mirror row_mask:0xf bank_mask:0xf
  v_mov_b32 v37, v36
  s_nop 1
  v_permlane16_swap_b32 v36, v37
  v_max_f32 v36, v36, v37
  v_mov_b32 v37, v36
  s_nop 1
  v_permlane32_swap_b32 v36, v37
  v_max_f32 v36, v36, v37
  v_max_f32_e64 v36, v36, -v16
  v_sub_f32_e64 v37, -v16, v36
  v_exp_f32 v37, v37
  v_xor_b32 v16, 0x80000000, v36
  v_sub_f32 v32, v32, v36
  v_sub_f32 v33, v33, v36
  v_mul_f32 v20, v20, v37
  v_mul_f32 v21, v21, v37
  v_mul_f32 v22, v22, v37
  v_mul_f32 v23, v23, v37
  v_mul_f32 v17, v17, v37
  s_nop 0
  s_setpc_b64 s[18:19]
.p2align 4
L_code_end:
.section .rodata,"a"
.p2align 6
.amdhsa_kernel concat_heads__gqa_block_cached__gqa_block_cached__decode_kernel
  .amdhsa_next_free_vgpr 256
  .amdhsa_next_free_sgpr 80
  .amdhsa_accum_offset 256
  .amdhsa_group_segment_fixed_size 0
  .amdhsa_kernarg_size 104
  .amdhsa_user_sgpr_count 2
  .amdhsa_user_sgpr_kernarg_segment_ptr 1
  .amdhsa_system_sgpr_workgroup_id_x 1
.end_amdhsa_kernel
```
